```python
import torch

def _softmax(x, axis=-1):
    return torch.softmax(x, dim=axis)
def _gelu(x):
    return torch.nn.functional.gelu(x, approximate="tanh")
def _silu(x):
    return torch.nn.functional.silu(x)
def _sigmoid(x):
    return torch.sigmoid(x)
def _layernorm(x, axis=-1, eps=1e-5):
    m = x.mean(dim=axis, keepdim=True)
    v = x.var(dim=axis, keepdim=True, unbiased=False)
    return (x - m) / torch.sqrt(v + eps)
def _scatter_add(tgt, idx, src, axis=0):
    return tgt.clone().index_add_(axis, idx, src)
def _segment_sum(src, seg, n):
    out = torch.zeros((n,) + src.shape[1:], dtype=src.dtype)
    return out.index_add_(0, seg, src)
def _pad(x, pw):
    flat = tuple(v for pair in reversed(pw) for v in pair)
    return torch.nn.functional.pad(x, flat)

kernel_name = 'parallel_sum__sliding_block_cached__dense_activation_gelu__decode'

def setup_inputs():

    _w = (lambda a: (lambda t: t.to(torch.bfloat16) if t.is_floating_point() else t)(torch.as_tensor(a)))
    def _A_setup():
        B, Sq, D = 1, 1, 512
        Hq, Hkv, Sk, Dh = 32, 8, 65536, 128
        assert Hq % Hkv == 0, (Hq, Hkv)
        return {
            "x": _w((lambda *s: torch.randn(*s, dtype=torch.bfloat16) * 0.05)(B, Sq, D)),
            "k_cache": _w((lambda *s: torch.randn(*s, dtype=torch.bfloat16) * 1.6)(B, Hkv, Sk, Dh)),
            "v_cache": _w((lambda *s: torch.randn(*s, dtype=torch.bfloat16) * 0.8)(B, Hkv, Sk, Dh)),
            "wq": _w((lambda *s: torch.randn(*s, dtype=torch.bfloat16) * 1.6)(D, Hq * Dh) * (D ** -0.5)),
            "wo": _w((lambda *s: torch.randn(*s, dtype=torch.bfloat16) * 0.8)(Hq * Dh, D) * ((Hq * Dh) ** -0.5)),
        }
    _A_in = _A_setup()

    def _B_setup():
        B, S, D, F = 1, 1, 512, 1792
        return {
            "x": _w((lambda *s: torch.randn(*s, dtype=torch.bfloat16) * 0.05)(B, S, D)),
            "w1": _w((lambda *s: torch.randn(*s, dtype=torch.bfloat16) * 0.4)(D, F) * (D ** -0.5)),
            "b1": _w((lambda *s: torch.randn(*s, dtype=torch.bfloat16) * 0.4)(F) * 0.01),
            "w2": _w((lambda *s: torch.randn(*s, dtype=torch.bfloat16) * 0.4)(F, D) * (F ** -0.5)),
            "b2": _w((lambda *s: torch.randn(*s, dtype=torch.bfloat16) * 0.4)(D) * 0.01),
        }
    _B_in = _B_setup()

    return {
        "A_x": _A_in["x"],
        "A_k_cache": _A_in["k_cache"],
        "A_v_cache": _A_in["v_cache"],
        "A_wq": _A_in["wq"],
        "A_wo": _A_in["wo"],
        "B_x": _B_in["x"],
        "B_w1": _B_in["w1"],
        "B_b1": _B_in["b1"],
        "B_w2": _B_in["w2"],
        "B_b2": _B_in["b2"],
    }

def reference(A_x, A_k_cache, A_v_cache, A_wq, A_wo, B_x, B_w1, B_b1, B_w2, B_b2):
    def _A_ref(x, k_cache, v_cache, wq, wo):
        B, Sq, D = x.shape
        Hq, Dh = 32, 128
        Hkv, Sk = k_cache.shape[1], k_cache.shape[2]
        W = min(4096, max(256, Sk // 4))
        rep = Hq // Hkv
        q = (lambda x, *d: x.permute(*d))((x @ wq).reshape(B, Sq, Hq, Dh), 0, 2, 1, 3)
        k = (lambda x, n, axis: torch.repeat_interleave(x, n, dim=axis))(k_cache[:, :, Sk - W:, :], rep, axis=1)
        v = (lambda x, n, axis: torch.repeat_interleave(x, n, dim=axis))(v_cache[:, :, Sk - W:, :], rep, axis=1)
        scores = torch.einsum("bhqd,bhkd->bhqk", q, k) * (Dh ** -0.5)
        p = _softmax(scores, axis=-1)
        o = torch.einsum("bhqk,bhkd->bhqd", p, v)
        return (lambda x, *d: x.permute(*d))(o, 0, 2, 1, 3).reshape(B, Sq, Hq * Dh) @ wo

    def _B_ref(x, w1, b1, w2, b2):
        h = torch.einsum("bsd,df->bsf", x, w1) + b1
        h = _gelu(h)
        return torch.einsum("bsf,fd->bsd", h, w2) + b2

    x = A_x
    xn = _layernorm(x, axis=-1)
    return x + _A_ref(xn, A_k_cache, A_v_cache, A_wq, A_wo) + _B_ref(xn, B_w1, B_b1, B_w2, B_b2)
```

```asm
; @launch grid=(256,1,1) block=(256,1,1) lds=124480
.amdgcn_target "amdgcn-amd-amdhsa--gfx950"
.text
.globl parallel_sum__sliding_block_cached__dense_activation_gelu__decode_kernel
.p2align 8
.type parallel_sum__sliding_block_cached__dense_activation_gelu__decode_kernel,@function
parallel_sum__sliding_block_cached__dense_activation_gelu__decode_kernel:
    s_cmp_ge_u32 s2, 256
    s_cbranch_scc1 L_end
    s_load_dwordx16 s[4:19], s[0:1], 0
    s_load_dwordx8 s[20:27], s[0:1], 64
    s_load_dwordx2 s[28:29], s[0:1], 96
    v_lshrrev_b32 v5, 6, v0
    v_and_b32 v1, 63, v0
    v_readfirstlane_b32 s32, v5
    v_lshrrev_b32 v2, 4, v1
    v_and_b32 v3, 15, v0
    s_and_b32 s30, s2, 7
    s_lshr_b32 s31, s2, 3
    s_mov_b32 s40, 0xff
    s_getreg_b32 s3, hwreg(HW_REG_XCC_ID, 0, 4)
    v_lshlrev_b32 v14, 4, v1
    v_lshlrev_b32 v6, 1, v2
    v_and_b32 v7, 7, v1
    v_xor_b32 v7, v7, v6
    v_lshlrev_b32 v7, 4, v7
    v_lshrrev_b32 v8, 3, v1
    v_lshl_or_b32 v11, v8, 13, v7
    v_mul_u32_u24 v8, 3584, v8
    v_add_u32 v12, v8, v7
    s_lshr_b32 s33, s31, 3
    s_lshl_b32 s33, s33, 2
    s_add_u32 s33, s33, s32
    s_lshl_b32 s33, s33, 18
    s_lshl_b32 s34, s30, 3
    s_and_b32 s35, s31, 7
    s_add_u32 s34, s34, s35
    s_lshl_b32 s34, s34, 7
    s_add_u32 s46, s33, s34
    s_and_b32 s41, s31, 7
    s_cmp_lg_u32 s41, 3
    s_cselect_b32 s59, 1, 0
    s_cmp_gt_u32 s41, 3
    s_cselect_b32 s33, 1, 0
    s_sub_u32 s43, s41, s33
    s_min_u32 s43, s43, 6
    s_lshr_b32 s42, s31, 3
    s_mul_i32 s34, s42, 7
    s_add_u32 s34, s34, s43
    s_lshl_b32 s34, s34, 7
    s_lshl_b32 s33, s30, 2
    s_add_u32 s33, s33, s32
    s_mul_i32 s33, s33, 57344
    s_add_u32 s47, s33, s34
    s_lshl_b32 s33, s32, 12
    s_add_u32 s48, s33, 65536
    s_lshl_b32 s33, s32, 11
    s_add_u32 s49, s33, 81920
    v_xor_b32 v5, v3, v2
    v_lshlrev_b32 v5, 4, v5
    v_lshl_or_b32 v9, v2, 8, v5
    v_xor_b32 v7, v3, v6
    v_lshlrev_b32 v7, 4, v7
    v_lshl_or_b32 v10, v2, 8, v7
    v_lshl_or_b32 v13, v2, 10, v7
    s_and_b32 s33, s31, 7
    s_lshl_b32 s34, s33, 10
    s_lshl_b32 s44, s32, 13
    s_or_b32 s44, s44, s34
    s_and_b32 s33, s33, 3
    s_lshl_b32 s35, s33, 6
    s_or_b32 s34, s34, s35
    v_xor_b32 v9, s34, v9
    s_lshr_b32 s53, s33, 1
    s_lshl_b32 s33, s33, 13
    s_lshl_b32 s34, s32, 11
    s_or_b32 s33, s33, s34
    s_or_b32 s45, s33, 32768
    v_xor_b32 v10, s33, v10
    s_lshl_b32 s33, s30, 24
    s_lshl_b32 s34, s31, 15
    s_add_u32 s33, s33, s34
    s_add_u32 s51, s33, 15728640
    s_lshl_b32 s34, s32, 13
    s_add_u32 s50, s51, s34
    s_waitcnt lgkmcnt(0)
    global_load_dwordx4 v[16:19], v14, s[4:5]
    s_add_u32 s10, s10, s46
    s_addc_u32 s11, s11, 0
    s_mov_b32 m0, s48
    s_load_dword s36, s[28:29], 0
    s_add_u32 s26, s28, 1048576
    s_addc_u32 s27, s29, 0
    global_load_lds_dwordx4 v11, s[10:11] nt
    s_xor_b32 m0, s48, 1024
    v_xor_b32 v5, 65536, v11
    global_load_lds_dwordx4 v5, s[10:11] nt
    s_xor_b32 m0, s48, 2048
    v_xor_b32 v5, 131072, v11
    global_load_lds_dwordx4 v5, s[10:11] nt
    s_xor_b32 m0, s48, 3072
    v_xor_b32 v5, 196608, v11
    global_load_lds_dwordx4 v5, s[10:11] nt
    s_add_u32 s16, s16, s47
    s_addc_u32 s17, s17, 0
    s_mov_b32 m0, s49
    s_cmp_lg_u32 s59, 0
    s_cselect_b32 exec_lo, -1, 1
    s_cselect_b32 exec_hi, -1, 0
    global_load_lds_dwordx4 v12, s[16:17] offset:0 nt
    v_add_u32 v5, 27648, v12
    global_load_lds_dwordx4 v5, s[16:17] offset:1024 nt
    s_mov_b64 exec, -1
    s_add_u32 s6, s6, s50
    s_addc_u32 s7, s7, 0
    s_add_u32 s8, s8, s51
    s_addc_u32 s9, s9, 0
    s_lshl_b32 s33, s30, 5
    s_add_u32 s33, s33, s31
    s_lshl_b32 s34, s33, 2
    s_add_u32 s34, s34, s32
    s_lshl_b32 s34, s34, 9
    s_add_u32 s34, s34, 262144
    v_lshl_add_u32 v6, v1, 7, s34
    s_lshl_b32 s34, s33, 7
    s_add_u32 s34, s34, 196608
    v_writelane_b32 v6, s34, 4
    s_mov_b64 exec, 31
    global_load_dword v4, v6, s[26:27] sc1
    s_mov_b64 exec, -1
    s_xor_b32 m0, s44, 0
    v_xor_b32 v5, 0, v9
    global_load_lds_dwordx4 v5, s[6:7] nt
    s_xor_b32 m0, s44, 1024
    v_xor_b32 v5, 1088, v9
    global_load_lds_dwordx4 v5, s[6:7] nt
    s_xor_b32 m0, s44, 2048
    v_xor_b32 v5, 2176, v9
    global_load_lds_dwordx4 v5, s[6:7] nt
    s_xor_b32 m0, s44, 3072
    v_xor_b32 v5, 3264, v9
    global_load_lds_dwordx4 v5, s[6:7] nt
    s_lshl_b32 s33, s32, 12
    s_add_u32 s57, s33, 90112
    s_lshl_b32 s34, s30, 3
    s_add_u32 s41, s41, s34
    s_mul_i32 s34, s30, 7
    s_add_u32 s43, s43, s34
    s_lshl_b32 s34, s42, 8
    s_lshl_b32 s33, s41, 2
    s_add_u32 s33, s33, s32
    s_lshl_b32 s33, s33, 14
    s_add_u32 s33, s33, s34
    s_add_u32 s12, s12, s33
    s_addc_u32 s13, s13, 0
    s_lshl_b32 s33, s43, 2
    s_add_u32 s33, s33, s32
    s_lshl_b32 s33, s33, 13
    s_add_u32 s33, s33, s34
    s_add_u32 s20, s20, s33
    s_addc_u32 s21, s21, 0
    v_and_b32 v5, 1, v1
    v_lshlrev_b32 v5, 4, v5
    v_bfe_u32 v6, v1, 1, 2
    v_add_u32 v5, v5, v6
    s_lshl_b32 s33, s43, 5
    s_lshl_b32 s34, s32, 2
    s_add_u32 s33, s33, s34
    v_add_lshl_u32 v20, v5, s33, 1
    s_lshr_b32 s33, s31, 4
    s_lshl_b32 s34, s30, 1
    s_add_u32 s50, s33, s34
    s_bfe_u32 s51, s31, 0x30001
    s_and_b32 s49, s31, 1
    s_or_b32 s49, s49, s32
    s_lshl_b32 s33, s50, 5
    s_lshl_b32 s34, s51, 1
    s_add_u32 s33, s33, s34
    v_and_b32 v5, 1, v2
    v_lshrrev_b32 v6, 1, v2
    v_lshl_add_u32 v5, v6, 4, v5
    v_add_lshl_u32 v23, v5, s33, 1
    global_load_ushort v20, v20, s[18:19]
    global_load_ushort v21, v23, s[4:5]
    global_load_ushort v22, v23, s[22:23]
    v_lshrrev_b32 v24, 2, v3
    v_and_b32 v25, 3, v3
    s_and_b32 s33, s32, 1
    s_lshl_b32 s33, s33, 2
    v_lshrrev_b32 v5, 1, v25
    v_add_u32 v5, s33, v5
    v_and_b32 v6, 1, v2
    v_lshlrev_b32 v6, 1, v6
    v_lshrrev_b32 v7, 1, v24
    v_add_lshl_u32 v6, v6, v7, 1
    v_xor_b32 v5, v5, v6
    v_lshlrev_b32 v5, 4, v5
    v_and_b32 v6, 1, v25
    v_lshl_or_b32 v8, v6, 3, v5
    v_lshl_add_u32 v7, v2, 2, v24
    v_lshl_add_u32 v8, v7, 7, v8
    s_cmp_lt_u32 s32, 2
    s_cselect_b32 s33, 0, 16384
    s_add_u32 s33, s33, 65536
    v_add_u32 v26, s33, v8
    v_xor_b32 v27, 32, v26
    s_lshl_b32 s33, s32, 2
    v_lshrrev_b32 v5, 1, v25
    v_add_u32 v5, s33, v5
    v_and_b32 v8, 7, v7
    v_lshlrev_b32 v8, 1, v8
    v_xor_b32 v5, v5, v8
    v_lshlrev_b32 v5, 4, v5
    v_lshl_or_b32 v5, v6, 3, v5
    v_lshl_add_u32 v5, v7, 8, v5
    v_add_u32 v32, 90112, v5
    v_xor_b32 v33, 32, v32
    s_lshl_b32 s33, s53, 14
    s_or_b32 s33, s33, 32768
    v_or_b32 v28, s33, v5
    v_xor_b32 v29, 32, v28
    v_xor_b32 v30, 0x4000, v28
    v_xor_b32 v31, 0x4000, v29
    v_xor_b32 v5, v3, v2
    v_lshlrev_b32 v5, 4, v5
    v_lshl_or_b32 v5, v3, 8, v5
    s_lshl_b32 s33, s32, 13
    v_add_u32 v34, s33, v5
    v_xor_b32 v35, 64, v34
    v_xor_b32 v36, 128, v34
    v_xor_b32 v37, 192, v34
    v_lshrrev_b32 v5, 2, v1
    v_lshlrev_b32 v5, 6, v5
    v_and_b32 v6, 1, v1
    v_lshl_or_b32 v5, v6, 5, v5
    v_bfe_u32 v6, v1, 1, 1
    v_lshl_or_b32 v5, v6, 3, v5
    s_lshl_b32 s33, s32, 10
    s_add_u32 s33, s33, 114688
    v_add_u32 v38, s33, v5
    s_lshr_b32 s34, s31, 3
    s_lshl_b32 s34, s34, 8
    s_lshl_b32 s35, s30, 7
    s_cmp_lt_u32 s32, 2
    s_cselect_b32 s34, s34, s35
    s_add_u32 s33, s33, s34
    v_lshl_add_u32 v39, v2, 4, s33
    s_bfe_u32 s33, s31, 0x20001
    s_lshl_b32 s33, s33, 11
    s_lshr_b32 s34, s31, 3
    s_lshl_b32 s34, s34, 9
    s_add_u32 s33, s33, s34
    s_and_b32 s34, s31, 1
    s_lshl_b32 s34, s34, 8
    s_add_u32 s33, s33, s34
    s_add_u32 s33, s33, 65536
    s_lshl_b32 s34, s30, 13
    s_add_u32 s33, s33, s34
    s_mul_i32 s34, s30, 7
    s_sub_u32 s34, s43, s34
    s_mul_i32 s35, s42, 7
    s_add_u32 s34, s34, s35
    s_lshl_b32 s34, s34, 11
    s_lshl_b32 s35, s30, 8
    s_add_u32 s34, s34, s35
    s_add_u32 s34, s34, 131072
    s_cmp_lt_u32 s32, 2
    s_cselect_b32 s33, s33, s34
    s_and_b32 s34, s32, 1
    s_lshl_b32 s34, s34, 7
    s_add_u32 s33, s33, s34
    v_lshl_add_u32 v40, v3, 3, s33
    s_waitcnt lgkmcnt(0)
    v_mov_b32 v62, 0x3b000000
    v_mov_b32 v202, 0x3db504f3
    v_mov_b32 v203, 0x3db504f3
    v_mov_b32 v204, 0x3fb8aa3b
    v_mov_b32 v205, 0x3fb8aa3b
    v_mov_b32 v206, 120128
    v_mov_b32 v208, 0x3f803f80
    v_mov_b32 v209, 0x3f803f80
    v_mov_b32 v210, 0x3f803f80
    v_mov_b32 v211, 0x3f803f80
    v_mov_b32 v216, 0xc0135761
    v_mov_b32 v217, 0xbdd2d3e8
    s_add_u32 s36, s36, 0x9E3779B9
    s_lshr_b32 s37, s36, 8
    s_lshr_b32 s38, s36, 16
    s_lshr_b32 s39, s36, 24
    v_and_b32 v5, 1, v1
    v_lshlrev_b32 v5, 4, v5
    v_lshrrev_b32 v41, v5, s36
    v_lshrrev_b32 v42, 8, v41
    v_and_b32 v5, 3, v1
    v_lshlrev_b32 v5, 3, v5
    v_lshrrev_b32 v43, v5, s36
    s_cmp_lt_u32 s32, 2
    s_cselect_b32 s33, s3, 0
    v_and_b32 v5, 1, v1
    v_add_u32 v5, -1, v5
    v_and_b32 v5, s33, v5
    v_xor_b32 v44, v5, v41
    v_and_b32 v5, 3, v1
    v_cmp_eq_u32 vcc, 0, v5
    v_mov_b32 v45, 0xff
    v_mov_b32 v6, 0xf0
    v_cndmask_b32 v45, v45, v6, vcc
    s_waitcnt vmcnt(14)
    v_lshlrev_b32 v46, 16, v16
    v_and_b32 v47, 0xffff0000, v16
    v_lshlrev_b32 v48, 16, v17
    v_and_b32 v49, 0xffff0000, v17
    v_lshlrev_b32 v50, 16, v18
    v_and_b32 v51, 0xffff0000, v18
    v_lshlrev_b32 v52, 16, v19
    v_and_b32 v53, 0xffff0000, v19
    v_add_f32 v5, v46, v47
    v_add_f32 v6, v48, v49
    v_add_f32 v7, v50, v51
    v_add_f32 v8, v52, v53
    v_add_f32 v5, v5, v6
    v_add_f32 v7, v7, v8
    v_add_f32 v5, v5, v7
    s_nop 1
    v_add_f32_dpp v5, v5, v5 row_ror:8 row_mask:0xf bank_mask:0xf
    s_nop 1
    v_add_f32_dpp v5, v5, v5 row_ror:4 row_mask:0xf bank_mask:0xf
    s_nop 1
    v_add_f32_dpp v5, v5, v5 row_ror:2 row_mask:0xf bank_mask:0xf
    s_nop 1
    v_add_f32_dpp v5, v5, v5 row_ror:1 row_mask:0xf bank_mask:0xf
    s_nop 1
    v_add_f32_dpp v5, v5, v5 row_bcast:15 row_mask:0xa bank_mask:0xf
    s_nop 1
    v_add_f32_dpp v5, v5, v5 row_bcast:31 row_mask:0xc bank_mask:0xf
    s_nop 0
    v_readlane_b32 s33, v5, 63
    s_nop 1
    v_mul_f32 v6, s33, v62
    v_sub_f32 v54, v46, v6
    v_sub_f32 v55, v47, v6
    v_sub_f32 v56, v48, v6
    v_sub_f32 v57, v49, v6
    v_sub_f32 v58, v50, v6
    v_sub_f32 v59, v51, v6
    v_sub_f32 v60, v52, v6
    v_sub_f32 v61, v53, v6
    v_mul_f32 v5, v54, v54
    v_mul_f32 v7, v55, v55
    v_fmac_f32 v5, v56, v56
    v_fmac_f32 v7, v57, v57
    v_fmac_f32 v5, v58, v58
    v_fmac_f32 v7, v59, v59
    v_fmac_f32 v5, v60, v60
    v_fmac_f32 v7, v61, v61
    v_add_f32 v5, v5, v7
    v_cvt_pk_bf16_f32 v6, v6, v6
    s_nop 0
    v_add_f32_dpp v5, v5, v5 row_ror:8 row_mask:0xf bank_mask:0xf
    s_nop 1
    v_add_f32_dpp v5, v5, v5 row_ror:4 row_mask:0xf bank_mask:0xf
    s_nop 1
    v_add_f32_dpp v5, v5, v5 row_ror:2 row_mask:0xf bank_mask:0xf
    s_nop 1
    v_add_f32_dpp v5, v5, v5 row_ror:1 row_mask:0xf bank_mask:0xf
    s_nop 1
    v_add_f32_dpp v5, v5, v5 row_bcast:15 row_mask:0xa bank_mask:0xf
    s_nop 1
    v_add_f32_dpp v5, v5, v5 row_bcast:31 row_mask:0xc bank_mask:0xf
    s_nop 0
    v_readlane_b32 s33, v5, 63
    v_and_b32 v6, 0xffff0000, v6
    v_sub_f32 v54, v46, v6
    v_sub_f32 v55, v47, v6
    v_sub_f32 v56, v48, v6
    v_sub_f32 v57, v49, v6
    v_sub_f32 v58, v50, v6
    v_sub_f32 v59, v51, v6
    v_sub_f32 v60, v52, v6
    v_sub_f32 v61, v53, v6
    v_mul_f32 v5, s33, v62
    v_cvt_pk_bf16_f32 v5, v5, v5
    v_and_b32 v5, 0xffff0000, v5
    v_add_f32 v5, 0x3727c5ac, v5
    v_cvt_pk_bf16_f32 v5, v5, v5
    v_and_b32 v5, 0xffff0000, v5
    v_sqrt_f32 v5, v5
    v_cvt_pk_bf16_f32 v16, v54, v55
    v_cvt_pk_bf16_f32 v17, v56, v57
    v_cvt_pk_bf16_f32 v18, v58, v59
    v_cvt_pk_bf16_f32 v19, v60, v61
    v_cvt_pk_bf16_f32 v5, v5, v5
    v_and_b32 v5, 0xffff0000, v5
    v_rcp_f32 v5, v5
    v_lshlrev_b32 v54, 16, v16
    v_and_b32 v55, 0xffff0000, v16
    v_lshlrev_b32 v56, 16, v17
    v_and_b32 v57, 0xffff0000, v17
    v_lshlrev_b32 v58, 16, v18
    v_and_b32 v59, 0xffff0000, v18
    v_lshlrev_b32 v60, 16, v19
    v_and_b32 v61, 0xffff0000, v19
    v_mul_f32 v54, v54, v5
    v_mul_f32 v55, v55, v5
    v_mul_f32 v56, v56, v5
    v_mul_f32 v57, v57, v5
    v_mul_f32 v58, v58, v5
    v_mul_f32 v59, v59, v5
    v_mul_f32 v60, v60, v5
    v_mul_f32 v61, v61, v5
    v_cvt_pk_bf16_f32 v16, v54, v55
    v_cvt_pk_bf16_f32 v17, v56, v57
    v_cvt_pk_bf16_f32 v18, v58, v59
    v_cvt_pk_bf16_f32 v19, v60, v61
    ds_write2_b64 v38, v[16:17], v[18:19] offset0:0 offset1:2
    s_lshl_b32 s33, s30, 13
    s_lshl_b32 s34, s32, 11
    s_add_u32 s33, s33, s34
    s_add_u32 s33, s33, 65536
    v_add_u32 v63, s33, v14
    s_waitcnt lgkmcnt(0)
    ds_read_b128 v[72:75], v39 offset:0
    ds_read_b128 v[76:79], v39 offset:64
    ds_read_b128 v[80:83], v39 offset:128
    ds_read_b128 v[84:87], v39 offset:192
    v_bfe_u32 v5, v1, 3, 2
    v_lshlrev_b32 v5, 6, v5
    v_and_b32 v6, 7, v1
    v_lshl_or_b32 v5, v6, 2, v5
    v_lshrrev_b32 v6, 5, v1
    v_lshl_or_b32 v5, v6, 5, v5
    s_mul_i32 s33, s32, 320
    s_add_u32 s33, s33, 118784
    v_add_u32 v64, s33, v5
    v_mul_u32_u24 v5, 320, v24
    v_lshl_add_u32 v5, v2, 4, v5
    v_add_u32 v65, 118784, v5
    v_lshlrev_b32 v5, 4, v24
    v_add_u32 v67, 120064, v5
    s_lshl_b32 s33, s32, 2
    v_add_u32 v66, s33, v67
    v_add_u32 v5, 120384, v14
    s_lshl_b32 s33, s32, 10
    v_add_u32 v68, s33, v5
    s_lshl_b32 s33, s53, 11
    v_add_u32 v70, s33, v5
    s_xor_b32 s33, s33, 2048
    v_add_u32 v71, s33, v5
    s_waitcnt vmcnt(8)
    s_barrier
    s_xor_b32 m0, s44, 4096
    v_xor_b32 v5, 4096, v9
    global_load_lds_dwordx4 v5, s[6:7] nt
    s_xor_b32 m0, s44, 5120
    v_xor_b32 v5, 5184, v9
    global_load_lds_dwordx4 v5, s[6:7] nt
    s_xor_b32 m0, s44, 6144
    v_xor_b32 v5, 6272, v9
    global_load_lds_dwordx4 v5, s[6:7] nt
    s_xor_b32 m0, s44, 7168
    v_xor_b32 v5, 7360, v9
    global_load_lds_dwordx4 v5, s[6:7] nt
    ds_read_b64_tr_b16 v[100:101], v26 offset:0
    ds_read_b64_tr_b16 v[102:103], v26 offset:2048
    ds_read_b64_tr_b16 v[104:105], v27 offset:0
    ds_read_b64_tr_b16 v[106:107], v27 offset:2048
    ds_read_b64_tr_b16 v[108:109], v26 offset:4096
    ds_read_b64_tr_b16 v[110:111], v26 offset:6144
    ds_read_b64_tr_b16 v[112:113], v27 offset:4096
    ds_read_b64_tr_b16 v[114:115], v27 offset:6144
    s_cmp_ge_u32 s32, 2
    s_cbranch_scc1 L_h
    ds_read_b64_tr_b16 v[116:117], v26 offset:8192
    ds_read_b64_tr_b16 v[118:119], v26 offset:10240
    ds_read_b64_tr_b16 v[120:121], v27 offset:8192
    ds_read_b64_tr_b16 v[122:123], v27 offset:10240
    ds_read_b64_tr_b16 v[124:125], v26 offset:12288
    ds_read_b64_tr_b16 v[126:127], v26 offset:14336
    ds_read_b64_tr_b16 v[128:129], v27 offset:12288
    ds_read_b64_tr_b16 v[130:131], v27 offset:14336
    s_waitcnt lgkmcnt(12)
    v_mfma_f32_16x16x32_bf16 v[132:135], v[72:75], v[100:103], 0
    v_mfma_f32_16x16x32_bf16 v[136:139], v[72:75], v[104:107], 0
    s_waitcnt lgkmcnt(8)
    v_mfma_f32_16x16x32_bf16 v[132:135], v[76:79], v[108:111], v[132:135]
    v_mfma_f32_16x16x32_bf16 v[136:139], v[76:79], v[112:115], v[136:139]
    s_waitcnt lgkmcnt(4)
    v_mfma_f32_16x16x32_bf16 v[132:135], v[80:83], v[116:119], v[132:135]
    v_mfma_f32_16x16x32_bf16 v[136:139], v[80:83], v[120:123], v[136:139]
    s_waitcnt lgkmcnt(0)
    v_mfma_f32_16x16x32_bf16 v[132:135], v[84:87], v[124:127], v[132:135]
    v_mfma_f32_16x16x32_bf16 v[136:139], v[84:87], v[128:131], v[136:139]
    s_branch L_pub1
L_h:
    s_cmp_eq_u32 s59, 0
    s_cbranch_scc1 L_nopub1
    s_waitcnt lgkmcnt(4)
    s_nop 2
    v_mfma_f32_16x16x32_bf16 v[132:135], v[72:75], v[100:103], 0
    v_mfma_f32_16x16x32_bf16 v[136:139], v[72:75], v[104:107], 0
    s_waitcnt lgkmcnt(0)
    v_mfma_f32_16x16x32_bf16 v[132:135], v[76:79], v[108:111], v[132:135]
    v_mfma_f32_16x16x32_bf16 v[136:139], v[76:79], v[112:115], v[136:139]
L_pub1:
    s_nop 7
    v_bfi_b32 v140, s40, v44, v132
    v_bfi_b32 v141, s40, v42, v136
    s_mov_b64 exec, 0xffff
    global_store_dwordx2 v40, v[140:141], s[28:29] sc1
    s_mov_b64 exec, -1
    s_branch L_pub1d
L_nopub1:
    s_mov_b64 exec, 1
    global_load_dword v4, v14, s[4:5]
    s_mov_b64 exec, -1
L_pub1d:
    s_mov_b32 s52, 0
    s_mov_b32 s58, 0
    s_mov_b32 s54, 0
    s_mov_b32 s55, 0
    s_lshl_b32 s33, s30, 16
    s_lshl_b32 s34, s31, 8
    s_add_u32 s33, s33, s34
    s_lshr_b32 s34, s32, 1
    s_lshl_b32 s34, s34, 13
    s_add_u32 s33, s33, s34
    s_and_b32 s34, s32, 1
    s_lshl_b32 s34, s34, 7
    s_add_u32 s33, s33, s34
    s_add_u32 s33, s33, 262144
    v_lshlrev_b32 v5, 14, v2
    v_lshl_or_b32 v5, v3, 3, v5
    v_add_u32 v88, s33, v5
    s_lshl_b32 s33, s41, 13
    s_lshl_b32 s34, s32, 6
    s_add_u32 s33, s33, s34
    s_add_u32 s33, s33, 262144
    v_lshlrev_b32 v5, 11, v2
    v_lshl_or_b32 v5, v3, 2, v5
    v_add_u32 v89, s33, v5
    s_lshl_b32 s33, s30, 12
    s_bfe_u32 s34, s31, 0x20001
    s_lshl_b32 s34, s34, 4
    s_add_u32 s33, s33, s34
    s_add_u32 s33, s33, 196608
    v_and_b32 v5, 7, v3
    v_lshl_add_u32 v5, v2, 3, v5
    v_lshl_add_u32 v90, v5, 7, s33
    s_lshr_b32 s33, s43, 1
    s_lshl_b32 s33, s33, 11
    s_and_b32 s34, s43, 1
    s_lshl_b32 s34, s34, 7
    s_add_u32 s33, s33, s34
    s_add_u32 s33, s33, 131072
    s_lshl_b32 s34, s30, 13
    s_add_u32 s34, s34, 65536
    s_cmp_lg_u32 s59, 0
    s_cselect_b32 s33, s33, s34
    s_lshl_b32 s34, s32, 5
    s_add_u32 s33, s33, s34
    v_lshrrev_b32 v5, 3, v1
    v_lshlrev_b32 v5, 8, v5
    v_and_b32 v6, 7, v1
    v_lshl_or_b32 v5, v6, 2, v5
    v_add_u32 v91, s33, v5
    s_lshr_b32 s33, s32, 1
    s_lshl_b32 s33, s33, 6
    s_and_b32 s34, s32, 1
    s_lshl_b32 s34, s34, 5
    s_add_u32 s33, s33, s34
    s_add_u32 s33, s33, 120160
    v_lshrrev_b32 v5, 3, v3
    v_lshlrev_b32 v5, 4, v5
    v_and_b32 v6, 1, v3
    v_lshl_or_b32 v5, v6, 3, v5
    v_bfe_u32 v7, v3, 1, 2
    v_lshl_or_b32 v5, v7, 1, v5
    v_add_u32 v92, s33, v5
    v_lshlrev_b32 v5, 3, v6
    v_lshl_or_b32 v5, v7, 1, v5
    s_lshl_b32 s33, s32, 4
    s_add_u32 s33, s33, 120288
    v_add_u32 v93, s33, v5
    v_lshlrev_b32 v5, 4, v2
    v_add_u32 v94, 120160, v5
    s_lshl_b32 s33, s41, 11
    s_lshl_b32 s34, s42, 9
    s_add_u32 s33, s33, s34
    s_lshl_b32 s34, s32, 7
    s_add_u32 s33, s33, s34
    s_add_u32 s33, s33, 786432
    v_lshl_add_u32 v95, v3, 3, s33
    s_lshl_b32 s33, s50, 7
    s_lshl_b32 s34, s51, 4
    s_add_u32 s33, s33, s34
    s_add_u32 s33, s33, 786432
    v_lshl_add_u32 v96, v1, 11, s33
    s_lshl_b32 s33, s30, 5
    s_add_u32 s33, s33, s31
    s_lshl_b32 s33, s33, 7
    s_add_u32 s33, s33, 196608
    v_lshl_add_u32 v97, v1, 2, s33
    s_waitcnt vmcnt(8)
    s_xor_b32 m0, s57, 0
    v_xor_b32 v5, 0, v13
    global_load_lds_dwordx4 v5, s[12:13] nt
    s_xor_b32 m0, s57, 1024
    v_xor_b32 v5, 4224, v13
    global_load_lds_dwordx4 v5, s[12:13] nt
    s_waitcnt vmcnt(5)
    s_xor_b32 m0, s57, 2048
    v_xor_b32 v5, 8192, v13
    global_load_lds_dwordx4 v5, s[12:13] nt
    s_xor_b32 m0, s57, 3072
    v_xor_b32 v5, 12416, v13
    global_load_lds_dwordx4 v5, s[12:13] nt
    s_waitcnt vmcnt(5)
    ds_read_b128 v[142:145], v34 offset:0
    ds_read_b128 v[146:149], v35 offset:0
    ds_read_b128 v[150:153], v36 offset:0
    ds_read_b128 v[154:157], v37 offset:0
    ds_read_b128 v[158:161], v34 offset:4096
    ds_read_b128 v[162:165], v35 offset:4096
    ds_read_b128 v[166:169], v36 offset:4096
    ds_read_b128 v[170:173], v37 offset:4096
    s_xor_b32 m0, s45, 0
    v_xor_b32 v5, 0, v10
    global_load_lds_dwordx4 v5, s[8:9] nt
    s_xor_b32 m0, s45, 1024
    v_xor_b32 v5, 1152, v10
    global_load_lds_dwordx4 v5, s[8:9] nt
    s_waitcnt vmcnt(2)
    global_load_dwordx4 v[174:177], v63, s[28:29] offset:0 sc1
    global_load_dwordx4 v[178:181], v63, s[28:29] offset:1024 sc1
    global_load_dword v182, v91, s[28:29] sc1
    s_barrier
    s_xor_b32 m0, s45, 8192
    v_xor_b32 v8, 8192, v10
    global_load_lds_dwordx4 v8, s[8:9] nt
    s_xor_b32 m0, s45, 9216
    v_xor_b32 v8, 9344, v10
    global_load_lds_dwordx4 v8, s[8:9] nt
    s_waitcnt vmcnt(2)
    v_xor_b32 v7, s36, v174
    v_xor_b32 v5, s37, v175
    v_bitop3_b32 v7, v7, v178, s36 bitop3:0xf6
    v_bitop3_b32 v5, v5, v176, s38 bitop3:0xf6
    v_bitop3_b32 v5, v5, v177, s39 bitop3:0xf6
    v_bitop3_b32 v5, v5, v179, s37 bitop3:0xf6
    v_bitop3_b32 v5, v5, v180, s38 bitop3:0xf6
    v_bitop3_b32 v5, v5, v181, s39 bitop3:0xf6
    v_and_b32 v8, 0xf0, v7
    v_and_or_b32 v5, v5, s40, v8
    v_cmp_ne_u32 vcc, 0, v5
    s_cbranch_vccz L_ok1
L_chk1:
    s_add_u32 s58, s58, 1
    s_cmp_ge_u32 s58, 2097152
    s_cbranch_scc1 L_end
    global_load_dwordx4 v[174:177], v63, s[28:29] offset:0 sc1
    global_load_dwordx4 v[178:181], v63, s[28:29] offset:1024 sc1
    global_load_dword v182, v91, s[28:29] sc1
    s_waitcnt vmcnt(0)
    v_xor_b32 v7, s36, v174
    v_xor_b32 v5, s37, v175
    v_bitop3_b32 v7, v7, v178, s36 bitop3:0xf6
    v_bitop3_b32 v5, v5, v176, s38 bitop3:0xf6
    v_bitop3_b32 v5, v5, v177, s39 bitop3:0xf6
    v_bitop3_b32 v5, v5, v179, s37 bitop3:0xf6
    v_bitop3_b32 v5, v5, v180, s38 bitop3:0xf6
    v_bitop3_b32 v5, v5, v181, s39 bitop3:0xf6
    v_and_b32 v8, 0xf0, v7
    v_and_or_b32 v5, v5, s40, v8
    v_cmp_ne_u32 vcc, 0, v5
    s_cbranch_vccnz L_chk1
L_ok1:
    v_xor_b32 v7, s36, v174
    v_xor_b32 v8, s36, v178
    v_xor_b32 v7, s3, v7
    v_bitop3_b32 v7, v7, v8, s3 bitop3:0xf6
    v_and_b32 v174, 0xffffff00, v174
    v_and_b32 v175, 0xffffff00, v175
    v_and_b32 v176, 0xffffff00, v176
    v_and_b32 v177, 0xffffff00, v177
    v_and_b32 v178, 0xffffff00, v178
    v_and_b32 v179, 0xffffff00, v179
    v_and_b32 v180, 0xffffff00, v180
    v_and_b32 v181, 0xffffff00, v181
    v_and_b32 v7, 15, v7
    v_add_f32 v174, v174, v178
    v_add_f32 v175, v175, v179
    v_add_f32 v176, v176, v180
    v_add_f32 v177, v177, v181
    v_cmp_ne_u32 s[34:35], 0, v7
    v_permlane32_swap_b32 v174, v175
    v_permlane32_swap_b32 v176, v177
    v_add_f32 v5, v174, v175
    v_add_f32 v6, v176, v177
    v_cvt_pk_bf16_f32 v5, v5, v6
    ds_write_b32 v64, v5
    s_xor_b32 m0, s45, 16384
    v_xor_b32 v8, 16384, v10
    global_load_lds_dwordx4 v8, s[8:9] nt
    s_xor_b32 m0, s45, 17408
    v_xor_b32 v8, 17536, v10
    global_load_lds_dwordx4 v8, s[8:9] nt
    s_waitcnt lgkmcnt(0)
    s_barrier
    ds_read_b128 v[72:75], v65 offset:0
    ds_read_b128 v[76:79], v65 offset:64
    ds_read_b128 v[80:83], v65 offset:128
    ds_read_b128 v[84:87], v65 offset:192
    s_waitcnt lgkmcnt(3)
    v_mfma_f32_16x16x32_bf16 v[188:191], v[142:145], v[72:75], 0
    v_mfma_f32_16x16x32_bf16 v[192:195], v[158:161], v[72:75], 0
    s_waitcnt lgkmcnt(2)
    v_mfma_f32_16x16x32_bf16 v[188:191], v[146:149], v[76:79], v[188:191]
    v_mfma_f32_16x16x32_bf16 v[192:195], v[162:165], v[76:79], v[192:195]
    s_waitcnt lgkmcnt(1)
    v_mfma_f32_16x16x32_bf16 v[188:191], v[150:153], v[80:83], v[188:191]
    v_mfma_f32_16x16x32_bf16 v[192:195], v[166:169], v[80:83], v[192:195]
    s_waitcnt lgkmcnt(0)
    v_mfma_f32_16x16x32_bf16 v[188:191], v[154:157], v[84:87], v[188:191]
    v_mfma_f32_16x16x32_bf16 v[192:195], v[170:173], v[84:87], v[192:195]
    s_xor_b32 m0, s45, 24576
    v_xor_b32 v8, 24576, v10
    global_load_lds_dwordx4 v8, s[8:9] nt
    s_xor_b32 m0, s45, 25600
    v_xor_b32 v8, 25728, v10
    global_load_lds_dwordx4 v8, s[8:9] nt
    s_or_b32 s33, s34, s35
    v_mov_b32 v6, s33
    s_lshl_b32 s33, s32, 2
    s_add_u32 s33, s33, 120128
    v_mov_b32 v7, s33
    s_mov_b64 exec, 1
    ds_write_b32 v7, v6
    s_mov_b64 exec, -1
    v_cvt_pk_bf16_f32 v196, v188, v189
    v_cvt_pk_bf16_f32 v197, v190, v191
    v_cvt_pk_bf16_f32 v198, v192, v193
    v_cvt_pk_bf16_f32 v199, v194, v195
    v_lshlrev_b32 v188, 16, v196
    v_and_b32 v189, 0xffff0000, v196
    v_lshlrev_b32 v190, 16, v197
    v_and_b32 v191, 0xffff0000, v197
    v_lshlrev_b32 v192, 16, v198
    v_and_b32 v193, 0xffff0000, v198
    v_lshlrev_b32 v194, 16, v199
    v_and_b32 v195, 0xffff0000, v199
    v_pk_mul_f32 v[188:189], v[188:189], v[202:203]
    v_pk_mul_f32 v[190:191], v[190:191], v[202:203]
    v_pk_mul_f32 v[192:193], v[192:193], v[202:203]
    v_pk_mul_f32 v[194:195], v[194:195], v[202:203]
    v_cvt_pk_bf16_f32 v196, v188, v189
    v_cvt_pk_bf16_f32 v197, v190, v191
    v_cvt_pk_bf16_f32 v198, v192, v193
    v_cvt_pk_bf16_f32 v199, v194, v195
    v_lshlrev_b32 v188, 16, v196
    v_and_b32 v189, 0xffff0000, v196
    v_lshlrev_b32 v190, 16, v197
    v_and_b32 v191, 0xffff0000, v197
    v_lshlrev_b32 v192, 16, v198
    v_and_b32 v193, 0xffff0000, v198
    v_lshlrev_b32 v194, 16, v199
    v_and_b32 v195, 0xffff0000, v199
    v_max3_f32 v5, v188, v189, v190
    v_max3_f32 v6, v191, v192, v193
    v_max3_f32 v5, v5, v194, v195
    v_max_f32 v5, v5, v6
    v_mov_b32 v6, v5
    s_nop 1
    v_permlane16_swap_b32 v5, v6
    v_max_f32 v5, v5, v6
    v_mov_b32 v6, v5
    s_nop 1
    v_permlane32_swap_b32 v5, v6
    v_max_f32 v5, v5, v6
    s_mov_b64 exec, 0x1111
    ds_write_b32 v66, v5
    s_mov_b64 exec, -1
    s_waitcnt lgkmcnt(0)
    s_barrier
    ds_read_b128 v[196:199], v67
    ds_read_b128 v[184:187], v206
    s_lshl_b32 s33, s32, 11
    s_add_u32 m0, s33, 106496
    s_cmp_lg_u32 s59, 0
    s_cselect_b32 exec_lo, -1, 1
    s_cselect_b32 exec_hi, -1, 0
    global_load_lds_dwordx4 v13, s[20:21] offset:0 nt
    v_xor_b32 v8, 128, v13
    v_add_u32 v8, 3072, v8
    global_load_lds_dwordx4 v8, s[20:21] offset:1024 nt
    s_mov_b64 exec, -1
    v_not_b32 v98, v41
    v_not_b32 v99, v42
    s_mov_b64 exec, 0xffff
    global_store_dwordx2 v95, v[98:99], s[28:29] sc1
    s_mov_b64 exec, -1
    s_waitcnt lgkmcnt(1)
    v_max3_f32 v5, v196, v197, v198
    v_max_f32 v5, v5, v199
    v_mul_f32 v200, v5, v204
    v_mul_f32 v201, v5, v204
    v_pk_fma_f32 v[188:189], v[188:189], v[204:205], v[200:201] neg_lo:[0,0,1] neg_hi:[0,0,1]
    v_pk_fma_f32 v[190:191], v[190:191], v[204:205], v[200:201] neg_lo:[0,0,1] neg_hi:[0,0,1]
    v_pk_fma_f32 v[192:193], v[192:193], v[204:205], v[200:201] neg_lo:[0,0,1] neg_hi:[0,0,1]
    v_pk_fma_f32 v[194:195], v[194:195], v[204:205], v[200:201] neg_lo:[0,0,1] neg_hi:[0,0,1]
    v_exp_f32 v188, v188
    v_exp_f32 v189, v189
    v_exp_f32 v190, v190
    v_exp_f32 v191, v191
    v_exp_f32 v192, v192
    v_exp_f32 v193, v193
    v_exp_f32 v194, v194
    v_exp_f32 v195, v195
    v_cvt_pk_bf16_f32 v196, v188, v189
    v_cvt_pk_bf16_f32 v197, v190, v191
    v_cvt_pk_bf16_f32 v198, v192, v193
    v_cvt_pk_bf16_f32 v199, v194, v195
    ds_write_b128 v68, v[196:199]
    s_waitcnt vmcnt(7)
    s_waitcnt lgkmcnt(0)
    s_barrier
    ds_read_b128 v[72:75], v70 offset:0
    ds_read_b128 v[76:79], v70 offset:1024
    ds_read_b128 v[80:83], v71 offset:0
    ds_read_b128 v[84:87], v71 offset:1024
    ds_read_b64_tr_b16 v[100:101], v28 offset:0
    ds_read_b64_tr_b16 v[102:103], v28 offset:4096
    ds_read_b64_tr_b16 v[104:105], v29 offset:0
    ds_read_b64_tr_b16 v[106:107], v29 offset:4096
    ds_read_b64_tr_b16 v[108:109], v28 offset:8192
    ds_read_b64_tr_b16 v[110:111], v28 offset:12288
    ds_read_b64_tr_b16 v[112:113], v29 offset:8192
    ds_read_b64_tr_b16 v[114:115], v29 offset:12288
    v_or3_b32 v8, v184, v185, v186
    v_or_b32 v8, v8, v187
    s_nop 0
    v_readfirstlane_b32 s48, v8
    s_cmp_eq_u32 s48, 0
    s_cselect_b64 s[18:19], s[26:27], s[28:29]
    s_cmp_lg_u32 s32, 0
    s_cbranch_scc1 L_noml0
    s_waitcnt lgkmcnt(8)
    v_mfma_f32_16x16x32_bf16 v[188:191], v[208:211], v[72:75], 0
    v_mfma_f32_16x16x32_bf16 v[188:191], v[208:211], v[76:79], v[188:191]
    v_mfma_f32_16x16x32_bf16 v[188:191], v[208:211], v[80:83], v[188:191]
    v_mfma_f32_16x16x32_bf16 v[188:191], v[208:211], v[84:87], v[188:191]
L_noml0:
    s_waitcnt lgkmcnt(4)
    v_mfma_f32_16x16x32_bf16 v[132:135], v[72:75], v[100:103], 0
    v_mfma_f32_16x16x32_bf16 v[136:139], v[72:75], v[104:107], 0
    s_waitcnt lgkmcnt(0)
    v_mfma_f32_16x16x32_bf16 v[132:135], v[76:79], v[108:111], v[132:135]
    v_mfma_f32_16x16x32_bf16 v[136:139], v[76:79], v[112:115], v[136:139]
    s_waitcnt vmcnt(3)
    s_barrier
    ds_read_b64_tr_b16 v[116:117], v30 offset:0
    ds_read_b64_tr_b16 v[118:119], v30 offset:4096
    ds_read_b64_tr_b16 v[120:121], v31 offset:0
    ds_read_b64_tr_b16 v[122:123], v31 offset:4096
    ds_read_b64_tr_b16 v[124:125], v30 offset:8192
    ds_read_b64_tr_b16 v[126:127], v30 offset:12288
    ds_read_b64_tr_b16 v[128:129], v31 offset:8192
    ds_read_b64_tr_b16 v[130:131], v31 offset:12288
    s_cmp_lg_u32 s32, 0
    s_cbranch_scc1 L_noml
    v_mov_b32 v212, s36
    s_mov_b64 s[34:35], 0x22222222
    s_mov_b64 vcc, 0x11111111
    v_cndmask_b32 v212, v212, v188, s[34:35]
    v_cndmask_b32 v212, v212, v200, vcc
    s_mov_b32 exec_hi, 0
    s_cmp_lg_u32 s48, 0
    s_cbranch_scc1 L_xs_ml
    global_store_dword v97, v212, s[18:19]
    s_branch L_xd_ml
L_xs_ml:
    global_store_dword v97, v212, s[18:19] sc1
L_xd_ml:
    s_mov_b64 exec, -1
L_noml:
    s_waitcnt lgkmcnt(4)
    v_mfma_f32_16x16x32_bf16 v[132:135], v[80:83], v[116:119], v[132:135]
    v_mfma_f32_16x16x32_bf16 v[136:139], v[80:83], v[120:123], v[136:139]
    s_waitcnt lgkmcnt(0)
    v_mfma_f32_16x16x32_bf16 v[132:135], v[84:87], v[124:127], v[132:135]
    v_mfma_f32_16x16x32_bf16 v[136:139], v[84:87], v[128:131], v[136:139]
    s_nop 6
    v_bfi_b32 v214, s40, v41, v132
    v_bfi_b32 v215, s40, v42, v136
    s_cmp_lg_u32 s48, 0
    s_cbranch_scc1 L_xs_o
    global_store_dwordx2 v88, v[214:215], s[18:19]
    s_branch L_xd_o
L_xs_o:
    global_store_dwordx2 v88, v[214:215], s[18:19] sc1
L_xd_o:
    ds_read_b64_tr_b16 v[100:101], v32 offset:0
    ds_read_b64_tr_b16 v[102:103], v32 offset:4096
    ds_read_b64_tr_b16 v[104:105], v33 offset:0
    ds_read_b64_tr_b16 v[106:107], v33 offset:4096
    ds_read_b64_tr_b16 v[108:109], v32 offset:8192
    ds_read_b64_tr_b16 v[110:111], v32 offset:12288
    ds_read_b64_tr_b16 v[112:113], v33 offset:8192
    ds_read_b64_tr_b16 v[114:115], v33 offset:12288
L_chkh:
    v_xor_b32 v5, v43, v182
    v_and_b32 v5, v45, v5
    v_cmp_ne_u32 vcc, 0, v5
    s_cbranch_vccz L_okh
    s_add_u32 s58, s58, 16
    s_cmp_ge_u32 s58, 33554432
    s_cbranch_scc1 L_end
    global_load_dword v182, v91, s[28:29] sc1
    s_waitcnt vmcnt(0)
    s_branch L_chkh
L_okh:
    v_and_b32 v182, 0xffffff00, v182
    s_nop 1
    v_add_f32_dpp v182, v182, v182 row_ror:8 row_mask:0xf bank_mask:0xf
    v_mov_b32 v8, v182
    s_nop 1
    v_permlane16_swap_b32 v182, v8
    v_add_f32 v182, v182, v8
    v_mov_b32 v8, v182
    s_nop 1
    v_permlane32_swap_b32 v182, v8
    v_add_f32 v182, v182, v8
    v_cvt_pk_bf16_f32 v182, v182, v182
    v_lshlrev_b32 v20, 16, v20
    v_and_b32 v182, 0xffff0000, v182
    v_add_f32 v182, v182, v20
    v_cvt_pk_bf16_f32 v182, v182, v182
    v_and_b32 v182, 0xffff0000, v182
    v_mul_f32 v7, v182, v182
    v_fma_f32 v7, v7, v217, v216
    v_mul_f32 v7, v7, v182
    v_exp_f32 v7, v7
    s_nop 0
    v_add_f32 v7, 1.0, v7
    v_rcp_f32 v7, v7
    s_nop 0
    v_mul_f32 v182, v182, v7
    v_cvt_pk_bf16_f32 v182, v182, v182
    s_mov_b64 exec, 0xff
    ds_write_b16 v93, v182
    s_mov_b64 exec, -1
    s_mov_b32 exec_lo, 0x00ff00ff
    s_mov_b32 exec_hi, 0x00ff00ff
L_poll_ml:
    global_load_dwordx4 v[218:221], v90, s[18:19] sc1
    s_add_u32 s54, s54, 1
    s_cmp_ge_u32 s54, 2097152
    s_cbranch_scc1 L_end
    s_waitcnt vmcnt(0)
    v_cmp_ne_u32 vcc, s36, v220
    s_cbranch_vccz L_ok_ml
    s_mov_b64 exec, vcc
    s_branch L_poll_ml
L_ok_ml:
    s_mov_b64 exec, -1
    global_load_dword v222, v89, s[18:19] offset:0 sc1
    global_load_dword v223, v89, s[18:19] offset:256 sc1
    global_load_dword v224, v89, s[18:19] offset:512 sc1
    global_load_dword v225, v89, s[18:19] offset:768 sc1
    global_load_dword v226, v89, s[18:19] offset:1024 sc1
    global_load_dword v227, v89, s[18:19] offset:1280 sc1
    global_load_dword v228, v89, s[18:19] offset:1536 sc1
    global_load_dword v229, v89, s[18:19] offset:1792 sc1
    v_max_f32_dpp v5, v218, v218 quad_perm:[1,0,3,2] row_mask:0xf bank_mask:0xf
    s_nop 1
    v_max_f32_dpp v5, v5, v5 quad_perm:[2,3,0,1] row_mask:0xf bank_mask:0xf
    s_nop 1
    v_max_f32_dpp v5, v5, v5 row_half_mirror row_mask:0xf bank_mask:0xf
    v_mov_b32 v6, v5
    s_nop 1
    v_permlane16_swap_b32 v5, v6
    v_max_f32 v5, v5, v6
    v_mov_b32 v6, v5
    s_nop 1
    v_permlane32_swap_b32 v5, v6
    v_max_f32 v5, v5, v6
    v_sub_f32 v5, v218, v5
    v_exp_f32 v230, v5
    s_nop 0
    v_mul_f32 v231, v230, v219
    s_nop 1
    v_add_f32_dpp v231, v231, v231 quad_perm:[1,0,3,2] row_mask:0xf bank_mask:0xf
    s_nop 1
    v_add_f32_dpp v231, v231, v231 quad_perm:[2,3,0,1] row_mask:0xf bank_mask:0xf
    s_nop 1
    v_add_f32_dpp v231, v231, v231 row_half_mirror row_mask:0xf bank_mask:0xf
    v_mov_b32 v6, v231
    s_nop 1
    v_permlane16_swap_b32 v231, v6
    v_add_f32 v231, v231, v6
    v_mov_b32 v6, v231
    s_nop 1
    v_permlane32_swap_b32 v231, v6
    v_add_f32 v231, v231, v6
    v_rcp_f32 v231, v231
    s_nop 0
    v_mul_f32 v230, v230, v231
L_chk2:
    s_waitcnt vmcnt(0)
    v_xor_b32 v5, v43, v222
    v_xor_b32 v6, v43, v223
    v_bitop3_b32 v5, v5, v224, v43 bitop3:0xf6
    v_bitop3_b32 v6, v6, v225, v43 bitop3:0xf6
    v_bitop3_b32 v5, v5, v226, v43 bitop3:0xf6
    v_bitop3_b32 v6, v6, v227, v43 bitop3:0xf6
    v_bitop3_b32 v5, v5, v228, v43 bitop3:0xf6
    v_bitop3_b32 v6, v6, v229, v43 bitop3:0xf6
    v_or_b32 v5, v5, v6
    v_and_b32 v5, s40, v5
    v_cmp_ne_u32 vcc, 0, v5
    s_cbranch_vccz L_ok2
    s_add_u32 s52, s52, 1
    s_cmp_ge_u32 s52, 2097152
    s_cbranch_scc1 L_end
    global_load_dword v222, v89, s[18:19] offset:0 sc1
    global_load_dword v223, v89, s[18:19] offset:256 sc1
    global_load_dword v224, v89, s[18:19] offset:512 sc1
    global_load_dword v225, v89, s[18:19] offset:768 sc1
    global_load_dword v226, v89, s[18:19] offset:1024 sc1
    global_load_dword v227, v89, s[18:19] offset:1280 sc1
    global_load_dword v228, v89, s[18:19] offset:1536 sc1
    global_load_dword v229, v89, s[18:19] offset:1792 sc1
    s_branch L_chk2
L_ok2:
    v_and_b32 v222, 0xffffff00, v222
    v_and_b32 v223, 0xffffff00, v223
    v_and_b32 v224, 0xffffff00, v224
    v_and_b32 v225, 0xffffff00, v225
    v_and_b32 v226, 0xffffff00, v226
    v_and_b32 v227, 0xffffff00, v227
    v_and_b32 v228, 0xffffff00, v228
    v_and_b32 v229, 0xffffff00, v229
    v_mul_f32_dpp v5, v230, v222 row_newbcast:0 row_mask:0xf bank_mask:0xf
    v_mul_f32_dpp v7, v230, v223 row_newbcast:1 row_mask:0xf bank_mask:0xf
    v_fmac_f32_dpp v5, v230, v224 row_newbcast:2 row_mask:0xf bank_mask:0xf
    v_fmac_f32_dpp v7, v230, v225 row_newbcast:3 row_mask:0xf bank_mask:0xf
    v_fmac_f32_dpp v5, v230, v226 row_newbcast:4 row_mask:0xf bank_mask:0xf
    v_fmac_f32_dpp v7, v230, v227 row_newbcast:5 row_mask:0xf bank_mask:0xf
    v_fmac_f32_dpp v5, v230, v228 row_newbcast:6 row_mask:0xf bank_mask:0xf
    v_fmac_f32_dpp v7, v230, v229 row_newbcast:7 row_mask:0xf bank_mask:0xf
    v_add_f32 v5, v5, v7
    v_mov_b32 v6, v5
    s_nop 1
    v_permlane16_swap_b32 v5, v6
    v_add_f32 v5, v5, v6
    v_mov_b32 v6, v5
    s_nop 1
    v_permlane32_swap_b32 v5, v6
    v_add_f32 v5, v5, v6
    v_cvt_pk_bf16_f32 v5, v5, v5
    s_mov_b64 exec, 0xffff
    ds_write_b16 v92, v5
    s_mov_b64 exec, -1
    s_waitcnt lgkmcnt(0)
    s_barrier
    ds_read_b128 v[72:75], v94 offset:0
    ds_read_b128 v[76:79], v94 offset:64
    ds_read_b128 v[80:83], v94 offset:128
    ds_read_b64_tr_b16 v[116:117], v32 offset:16384
    ds_read_b64_tr_b16 v[118:119], v32 offset:20480
    ds_read_b64_tr_b16 v[120:121], v33 offset:16384
    ds_read_b64_tr_b16 v[122:123], v33 offset:20480
    s_waitcnt lgkmcnt(6)
    v_mfma_f32_16x16x32_bf16 v[132:135], v[72:75], v[100:103], 0
    v_mfma_f32_16x16x32_bf16 v[136:139], v[72:75], v[104:107], 0
    s_waitcnt lgkmcnt(5)
    v_mfma_f32_16x16x32_bf16 v[132:135], v[76:79], v[108:111], v[132:135]
    v_mfma_f32_16x16x32_bf16 v[136:139], v[76:79], v[112:115], v[136:139]
    s_cmp_eq_u32 s59, 0
    s_cbranch_scc1 L_nomlp
    s_waitcnt lgkmcnt(0)
    v_mfma_f32_16x16x32_bf16 v[132:135], v[80:83], v[116:119], v[132:135]
    v_mfma_f32_16x16x32_bf16 v[136:139], v[80:83], v[120:123], v[136:139]
L_nomlp:
    s_nop 7
    v_bfi_b32 v140, s40, v41, v132
    v_bfi_b32 v141, s40, v42, v136
    s_mov_b64 exec, 0xffff
    global_store_dwordx2 v95, v[140:141], s[28:29] sc1
    s_mov_b64 exec, -1
    s_cmp_lg_u32 s49, 0
    s_cbranch_scc1 L_fin
    v_lshlrev_b32 v21, 16, v21
    v_lshlrev_b32 v22, 16, v22
    v_add_f32 v21, v21, v22
    s_sleep 13
L_poll3:
    global_load_dwordx4 v[174:177], v96, s[28:29] sc1
    s_waitcnt vmcnt(0)
    v_xor_b32 v5, s36, v174
    v_bitop3_b32 v5, v5, v175, s37 bitop3:0xf6
    v_bitop3_b32 v5, v5, v176, s38 bitop3:0xf6
    v_bitop3_b32 v5, v5, v177, s39 bitop3:0xf6
    v_and_b32 v5, s40, v5
    v_cmp_ne_u32 vcc, 0, v5
    s_cbranch_vccz L_ok3
    s_add_u32 s55, s55, 1
    s_cmp_ge_u32 s55, 2097152
    s_cbranch_scc1 L_end
    s_mov_b64 exec, vcc
    s_sleep 1
    s_branch L_poll3
L_ok3:
    s_mov_b64 exec, -1
    v_and_b32 v174, 0xffffff00, v174
    v_and_b32 v175, 0xffffff00, v175
    v_and_b32 v176, 0xffffff00, v176
    v_and_b32 v177, 0xffffff00, v177
    v_permlane32_swap_b32 v174, v175
    s_nop 0
    v_permlane32_swap_b32 v176, v177
    v_add_f32 v5, v174, v175
    v_add_f32 v6, v176, v177
    s_nop 1
    v_permlane16_swap_b32 v5, v6
    v_add_f32 v5, v5, v6
    s_nop 1
    v_add_f32_dpp v5, v5, v5 row_ror:8 row_mask:0xf bank_mask:0xf
    s_nop 1
    v_add_f32_dpp v5, v5, v5 row_ror:4 row_mask:0xf bank_mask:0xf
    s_nop 1
    v_add_f32_dpp v5, v5, v5 row_ror:2 row_mask:0xf bank_mask:0xf
    s_nop 1
    v_add_f32_dpp v5, v5, v5 row_ror:1 row_mask:0xf bank_mask:0xf
    v_add_f32 v5, v5, v21
    v_cvt_pk_bf16_f32 v5, v5, v5
    s_mov_b32 exec_lo, 0x10001
    s_mov_b32 exec_hi, 0x10001
    global_store_short v23, v5, s[24:25]
    s_cmp_lg_u32 s2, 0
    s_cbranch_scc1 L_fin
    s_mov_b64 exec, 1
    v_mov_b32 v6, 0
    v_mov_b32 v7, s36
    global_store_dword v6, v7, s[28:29]
L_fin:
L_end:
    s_endpgm
.section .rodata,"a"
.p2align 6
.amdhsa_kernel parallel_sum__sliding_block_cached__dense_activation_gelu__decode_kernel
  .amdhsa_next_free_vgpr 232
  .amdhsa_next_free_sgpr 64
  .amdhsa_accum_offset 232
  .amdhsa_group_segment_fixed_size 0
  .amdhsa_kernarg_size 104
  .amdhsa_user_sgpr_count 2
  .amdhsa_user_sgpr_kernarg_segment_ptr 1
  .amdhsa_system_sgpr_workgroup_id_x 1
  .amdhsa_float_denorm_mode_32 3
  .amdhsa_ieee_mode 0
  .amdhsa_dx10_clamp 0
.end_amdhsa_kernel
```
